```python
import torch

def _softmax(x, axis=-1):
    return torch.softmax(x, dim=axis)
def _gelu(x):
    return torch.nn.functional.gelu(x, approximate="tanh")
def _silu(x):
    return torch.nn.functional.silu(x)
def _sigmoid(x):
    return torch.sigmoid(x)
def _layernorm(x, axis=-1, eps=1e-5):
    m = x.mean(dim=axis, keepdim=True)
    v = x.var(dim=axis, keepdim=True, unbiased=False)
    return (x - m) / torch.sqrt(v + eps)
def _scatter_add(tgt, idx, src, axis=0):
    return tgt.clone().index_add_(axis, idx, src)
def _segment_sum(src, seg, n):
    out = torch.zeros((n,) + src.shape[1:], dtype=src.dtype)
    return out.index_add_(0, seg, src)
def _pad(x, pw):
    flat = tuple(v for pair in reversed(pw) for v in pair)
    return torch.nn.functional.pad(x, flat)

kernel_name = 'standalone__grouped__vision'

def setup_inputs():

    _w = (lambda a: (lambda t: t.to(torch.bfloat16) if t.is_floating_point() else t)(torch.as_tensor(a)))
    H = W = 384
    G = 4
    Cg = max(96 // G, 2)
    C = G * Cg
    k = 3
    scale = 1.0 / (k * Cg ** 0.5)
    return {
        "x": _w((lambda *s: torch.randn(*s, dtype=torch.bfloat16) * 0.05)(1, H, W, C)),
        "w": _w((lambda *s: torch.randn(*s, dtype=torch.bfloat16) * 0.05)(k, k, G, Cg, Cg) * scale),
    }

def reference(x, w):
    B, H, W, C = x.shape
    k = w.shape[0]
    G = w.shape[2]
    Cg = C // G
    pad = k // 2
    xp = _pad(x, ((0,0),(pad,pad),(pad,pad),(0,0)))
    xg = xp.reshape(B, H + 2 * pad, W + 2 * pad, G, Cg)
    out = torch.zeros_like(x).reshape(B, H, W, G, Cg)
    for i in range(k):
        for j in range(k):
            out = out + torch.einsum('bhwgc,gcd->bhwgd', xg[:, i:i+H, j:j+W, :, :], w[i, j])
    return out.reshape(B, H, W, C)
```

```asm
; @launch grid=(256,1,1) block=(512,1,1) lds=163840
.amdgcn_target "amdgcn-amd-amdhsa--gfx950"
.text
.p2align 12
.fill 832, 4, 0xbf800000
.globl standalone__grouped__vision_kernel
.p2align 8
.type standalone__grouped__vision_kernel,@function
standalone__grouped__vision_kernel:
    s_load_dwordx4 s[4:7], s[0:1], 0
    s_load_dwordx2 s[8:9], s[0:1], 16
    s_cmp_ge_u32 s2, 256
    s_cbranch_scc1 L_end
    s_getpc_b64 s[42:43]
    s_and_b32 s42, s42, 0xffffff00
    v_lshlrev_b32 v2, 4, v0
    v_min_u32 v2, L_codeend-standalone__grouped__vision_kernel-12, v2
    v_mov_b32 v3, s43
    v_add_co_u32 v2, vcc, s42, v2
    s_nop 1
    v_addc_co_u32 v3, vcc, 0, v3, vcc
    global_load_dwordx4 v[8:11], v[2:3], off
    v_lshrrev_b32 v4, 6, v0
    v_and_b32 v1, 63, v0
    v_readfirstlane_b32 s24, v4
    s_and_b32 s29, s2, 1
    s_bfe_u32 s30, s2, 0x20003
    s_lshl2_add_u32 s25, s29, s30
    s_bfe_u32 s29, s2, 0x20001
    s_lshr_b32 s30, s2, 5
    s_lshl3_add_u32 s29, s29, s30
    s_mul_i32 s26, s29, 12
    s_mov_b32 s46, 0x40000
    s_mov_b32 s15, 0x20000
    s_cmp_lt_u32 s24, 4
    s_cbranch_scc1 L_comp
    s_cmp_lt_u32 s24, 6
    s_cbranch_scc1 L_load
    s_sub_u32 s36, s24, 6
    v_mov_b32 v16, 163776
    v_mov_b64 v[20:21], 0
    v_mov_b64 v[22:23], 0
    ds_write_b128 v16, v[20:23]
    ds_write_b128 v16, v[20:23] offset:16
    v_lshlrev_b32 v17, 4, v1
    s_lshl_b32 s37, s36, 10
    s_add_u32 s38, s37, 120768
    s_mov_b32 s14, 41472
    s_mov_b32 s32, 21
    s_waitcnt lgkmcnt(0)
    s_mov_b32 s12, s6
    s_mov_b32 s13, s7
L_w0:
    s_mov_b32 m0, s38
    s_add_u32 s38, s38, 2048
    buffer_load_dwordx4 v17, s[12:15], s37 offen lds
    s_add_u32 s37, s37, 2048
    s_cmp_lg_u32 s32, 1
    s_cbranch_scc1 L_w1
    s_barrier
L_w1:
    s_sub_u32 s32, s32, 1
    s_cmp_lg_u32 s32, 0
    s_cbranch_scc1 L_w0
    s_branch L_store2
L_load:
    s_sub_u32 s34, s24, 4
    v_add_u32 v4, 0, v1
    v_mul_u32_u24 v4, 683, v4
    v_bfe_u32 v4, v4, 15, 2
    v_xor_b32 v4, v4, v1
    v_lshlrev_b32 v15, 4, v4
    v_add_u32 v4, 64, v1
    v_mul_u32_u24 v4, 683, v4
    v_bfe_u32 v4, v4, 15, 2
    v_xor_b32 v4, v4, v1
    v_lshlrev_b32 v13, 4, v4
    v_add_u32 v4, 128, v1
    v_mul_u32_u24 v4, 683, v4
    v_bfe_u32 v4, v4, 15, 2
    v_xor_b32 v4, v4, v1
    v_lshlrev_b32 v14, 4, v4
    v_bfrev_b32 v5, 1
    s_cmp_eq_u32 s25, 0
    s_cselect_b32 s29, 12, 0
    v_cmp_gt_u32 vcc, s29, v1
    s_cmp_eq_u32 s25, 7
    s_cselect_b32 s29, 11, 63
    v_cndmask_b32 v12, v15, v5, vcc
    v_cmp_lt_u32 vcc, s29, v1
    s_add_u32 s39, s26, s34
    s_sub_u32 s39, s39, 1
    v_cndmask_b32 v16, v15, v5, vcc
    s_sub_u32 s29, s26, 1
    s_mul_i32 s29, s29, 73728
    s_mul_i32 s30, s25, 9216
    s_add_u32 s29, s29, s30
    s_sub_u32 s29, s29, 192
    s_ashr_i32 s30, s29, 31
    s_sub_u32 s38, 28311552, s29
    s_mul_i32 s36, s34, 73728
    s_mul_i32 s37, s34, 9600
    v_mov_b32 v17, 163792
    v_lshl_add_u32 v17, s34, 2, v17
    v_mov_b32 v18, 1
    s_waitcnt lgkmcnt(0)
    s_add_u32 s12, s4, s29
    s_addc_u32 s13, s5, s30
    s_cmp_lt_u32 s39, 384
    s_cselect_b32 s14, s38, 0
    s_mov_b32 m0, s37
    s_add_u32 s29, s36, 3072
    buffer_load_dwordx4 v12, s[12:15], s36 offen nt lds
    buffer_load_dwordx4 v13, s[12:15], s36 offen offset:1024 nt lds
    buffer_load_dwordx4 v14, s[12:15], s36 offen offset:2048 nt lds
    s_add_u32 m0, s37, 3072
    s_add_u32 s30, s36, 6144
    buffer_load_dwordx4 v15, s[12:15], s29 offen nt lds
    buffer_load_dwordx4 v13, s[12:15], s29 offen offset:1024 nt lds
    buffer_load_dwordx4 v14, s[12:15], s29 offen offset:2048 nt lds
    s_add_u32 m0, s37, 6144
    s_add_u32 s39, s39, 2
    buffer_load_dwordx4 v15, s[12:15], s30 offen nt lds
    buffer_load_dwordx4 v13, s[12:15], s30 offen offset:1024 nt lds
    buffer_load_dwordx4 v14, s[12:15], s30 offen offset:2048 nt lds
    s_mov_b64 exec, 0xffffff
    buffer_load_dwordx4 v16, s[12:15], s30 offen offset:3072 nt lds
    s_mov_b64 exec, -1
    s_add_u32 s36, s36, 147456
    s_add_u32 s37, s37, 19200
    s_barrier
    s_call_b64 s[20:21], L_ldrow
    s_waitcnt vmcnt(10)
    ds_write_b32 v17, v18
    v_add_u32 v18, 1, v18
    s_call_b64 s[20:21], L_ldrow
    s_call_b64 s[20:21], L_ldrow
    s_call_b64 s[20:21], L_ldrow
    s_waitcnt vmcnt(30)
    ds_write_b32 v17, v18
    v_add_u32 v18, 1, v18
    s_call_b64 s[20:21], L_ldrow
L_ldw:
    s_sub_u32 s46, s46, 1
    s_cbranch_scc1 L_end
    v_mov_b32 v4, 163776
    ds_read_b128 v[20:23], v4
    s_waitcnt lgkmcnt(0)
    v_min_u32 v20, v20, v21
    v_min3_u32 v20, v20, v22, v23
    s_nop 0
    v_readfirstlane_b32 s29, v20
    s_cmp_eq_u32 s29, 0
    s_cbranch_scc1 L_ldw
    s_call_b64 s[20:21], L_ldrow
    s_waitcnt vmcnt(40)
    ds_write_b32 v17, v18
    v_add_u32 v18, 1, v18
    s_waitcnt vmcnt(30)
    ds_write_b32 v17, v18
    v_add_u32 v18, 1, v18
    s_waitcnt vmcnt(20)
    ds_write_b32 v17, v18
    v_add_u32 v18, 1, v18
    s_waitcnt vmcnt(10)
    ds_write_b32 v17, v18
    v_add_u32 v18, 1, v18
    s_waitcnt vmcnt(0)
    ds_write_b32 v17, v18
    s_branch L_end
L_ldrow:
    s_cmp_lt_u32 s39, 384
    s_cselect_b32 s14, s38, 0
    s_mov_b32 m0, s37
    s_add_u32 s29, s36, 3072
    buffer_load_dwordx4 v12, s[12:15], s36 offen nt lds
    buffer_load_dwordx4 v13, s[12:15], s36 offen offset:1024 nt lds
    buffer_load_dwordx4 v14, s[12:15], s36 offen offset:2048 nt lds
    s_add_u32 m0, s37, 3072
    s_add_u32 s30, s36, 6144
    buffer_load_dwordx4 v15, s[12:15], s29 offen nt lds
    buffer_load_dwordx4 v13, s[12:15], s29 offen offset:1024 nt lds
    buffer_load_dwordx4 v14, s[12:15], s29 offen offset:2048 nt lds
    s_add_u32 m0, s37, 6144
    s_add_u32 s39, s39, 2
    buffer_load_dwordx4 v15, s[12:15], s30 offen nt lds
    buffer_load_dwordx4 v13, s[12:15], s30 offen offset:1024 nt lds
    buffer_load_dwordx4 v14, s[12:15], s30 offen offset:2048 nt lds
    s_mov_b64 exec, 0xffffff
    buffer_load_dwordx4 v16, s[12:15], s30 offen offset:3072 nt lds
    s_mov_b64 exec, -1
    s_add_u32 s36, s36, 147456
    s_add_u32 s37, s37, 19200
    s_setpc_b64 s[20:21]
L_store2:
    v_mov_b32 v6, 163800
    v_lshl_add_u32 v6, s36, 2, v6
    v_mov_b32 v7, 1
    s_waitcnt vmcnt(7)
    ds_write_b32 v6, v7
    v_mov_b32 v7, 2
    s_add_u32 s29, s26, s36
    s_mul_i32 s34, s29, 73728
    s_mul_i32 s30, s25, 9216
    s_add_u32 s34, s34, s30
    s_waitcnt vmcnt(0)
    ds_write_b32 v6, v7
    s_mul_i32 s29, s36, 9600
    v_add_u32 v4, 12, v1
    v_lshlrev_b32 v15, 4, v4
    v_add_u32 v15, s29, v15
    v_mul_u32_u24 v5, 683, v4
    v_bfe_u32 v5, v5, 15, 2
    v_xor_b32 v5, v4, v5
    v_lshlrev_b32 v5, 4, v5
    v_subrev_u32 v12, 192, v5
    v_add_u32 v4, 64, v4
    v_mul_u32_u24 v5, 683, v4
    v_bfe_u32 v5, v5, 15, 2
    v_xor_b32 v5, v4, v5
    v_lshlrev_b32 v5, 4, v5
    v_subrev_u32 v13, 192, v5
    v_add_u32 v4, 64, v4
    v_mul_u32_u24 v5, 683, v4
    v_bfe_u32 v5, v5, 15, 2
    v_xor_b32 v5, v4, v5
    v_lshlrev_b32 v5, 4, v5
    v_subrev_u32 v14, 192, v5
    s_mov_b32 s35, 2
    s_mov_b32 s39, 0
    s_movk_i32 s40, 3072
    s_mov_b32 s12, s8
    s_mov_b32 s13, s9
    s_mov_b32 s14, 28311552
L_hold:
    s_sub_u32 s46, s46, 1
    s_cbranch_scc1 L_end
    s_sleep 1
    ds_read_b64 v[20:21], v16 offset:16
    s_waitcnt lgkmcnt(0)
    v_min_u32 v20, v20, v21
    s_nop 0
    v_readfirstlane_b32 s29, v20
    s_cmp_ge_u32 s29, 7
    s_cbranch_scc0 L_hold
L_st0:
    s_sub_u32 s46, s46, 1
    s_cbranch_scc1 L_end
    ds_read_b128 v[20:23], v16
    s_waitcnt lgkmcnt(0)
    v_min_u32 v20, v20, v21
    v_min3_u32 v20, v20, v22, v23
    s_nop 0
    v_readfirstlane_b32 s29, v20
    s_cmp_ge_u32 s29, s35
    s_cbranch_scc1 L_st1
    s_sleep 1
    s_branch L_st0
L_st1:
    ds_read_b128 v[24:27], v15 offset:0
    ds_read_b128 v[28:31], v15 offset:1024
    ds_read_b128 v[32:35], v15 offset:2048
    s_add_u32 s39, s39, 1
    s_cmp_eq_u32 s39, 3
    s_cselect_b32 s39, 0, s39
    s_cselect_b32 s30, 13056, s40
    s_cselect_b32 s31, 141312, s40
    v_add_u32 v15, s30, v15
    s_waitcnt lgkmcnt(2)
    buffer_store_dwordx4 v[24:27], v12, s[12:15], s34 offen sc1
    s_waitcnt lgkmcnt(1)
    buffer_store_dwordx4 v[28:31], v13, s[12:15], s34 offen sc1
    s_waitcnt lgkmcnt(0)
    buffer_store_dwordx4 v[32:35], v14, s[12:15], s34 offen sc1
    s_add_u32 s34, s34, s31
    s_add_u32 s35, s35, 1
    s_cmp_ge_u32 s35, 20
    s_cbranch_scc1 L_st2
    s_cmp_ge_u32 s29, s35
    s_cbranch_scc1 L_st1
    s_branch L_st0
L_st2:
    s_branch L_end
L_comp2:
    ds_read_b128 v[32:35], v12
    ds_read_b128 v[36:39], v13
    ds_read_b128 v[40:43], v12 offset:9600
    ds_read_b128 v[44:47], v13 offset:9600
    ds_read_b128 v[48:51], v14
    s_waitcnt lgkmcnt(4)
    v_mfma_f32_16x16x32_bf16 v[168:171], v[64:67], v[32:35], 0
    v_mfma_f32_16x16x32_bf16 v[172:175], v[68:71], v[32:35], 0
    ds_read_b128 v[32:35], v12 offset:3072
    s_waitcnt lgkmcnt(4)
    v_mfma_f32_16x16x32_bf16 v[168:171], v[104:107], v[36:39], v[168:171]
    v_mfma_f32_16x16x32_bf16 v[172:175], v[108:111], v[36:39], v[172:175]
    ds_read_b128 v[36:39], v13 offset:3072
    s_waitcnt lgkmcnt(4)
    v_mfma_f32_16x16x32_bf16 v[168:171], v[80:83], v[40:43], v[168:171]
    v_mfma_f32_16x16x32_bf16 v[172:175], v[84:87], v[40:43], v[172:175]
    v_mfma_f32_16x16x32_bf16 v[176:179], v[88:91], v[40:43], 0
    ds_read_b128 v[40:43], v12 offset:12672
    s_waitcnt lgkmcnt(4)
    v_mfma_f32_16x16x32_bf16 v[168:171], v[120:123], v[44:47], v[168:171]
    v_mfma_f32_16x16x32_bf16 v[172:175], v[124:127], v[44:47], v[172:175]
    v_mfma_f32_16x16x32_bf16 v[176:179], v[128:131], v[44:47], v[176:179]
    ds_read_b128 v[44:47], v13 offset:12672
    s_waitcnt lgkmcnt(4)
    v_mfma_f32_16x16x32_bf16 v[168:171], v[144:147], v[48:51], v[168:171]
    v_mfma_f32_16x16x32_bf16 v[172:175], v[148:151], v[48:51], v[172:175]
    v_mfma_f32_16x16x32_bf16 v[176:179], v[152:155], v[48:51], v[176:179]
    ds_read_b128 v[48:51], v14 offset:3072
L_poll2:
    s_sub_u32 s46, s46, 1
    s_cbranch_scc1 L_end
    ds_read_b64 v[20:21], v24
    s_waitcnt lgkmcnt(0)
    v_min_u32 v20, v20, v21
    s_nop 0
    v_readfirstlane_b32 s35, v20
    s_cmp_ge_u32 s35, 2
    s_cbranch_scc0 L_poll2
    v_mfma_f32_16x16x32_bf16 v[192:195], v[64:67], v[32:35], 0
    ds_read_b64_tr_b16 v[52:53], v156 offset:27648
    ds_read_b64_tr_b16 v[54:55], v156 offset:27840
    v_mfma_f32_16x16x32_bf16 v[196:199], v[68:71], v[32:35], 0
    ds_read_b128 v[32:35], v12 offset:6144
    ds_read_b64_tr_b16 v[56:57], v157 offset:13824
    ds_read_b64_tr_b16 v[58:59], v157 offset:14016
    v_mfma_f32_16x16x32_bf16 v[192:195], v[104:107], v[36:39], v[192:195]
    ds_read_b64_tr_b16 v[60:61], v156 offset:13840
    ds_read_b64_tr_b16 v[62:63], v156 offset:14032
    v_mfma_f32_16x16x32_bf16 v[196:199], v[108:111], v[36:39], v[196:199]
    ds_read_b128 v[36:39], v13 offset:6144
    ds_read_b64_tr_b16 v[92:93], v160 offset:27648
    ds_read_b64_tr_b16 v[94:95], v160 offset:27840
    v_mfma_f32_16x16x32_bf16 v[192:195], v[80:83], v[40:43], v[192:195]
    ds_read_b64_tr_b16 v[96:97], v161 offset:13824
    ds_read_b64_tr_b16 v[98:99], v161 offset:14016
    v_mfma_f32_16x16x32_bf16 v[196:199], v[84:87], v[40:43], v[196:199]
    ds_read_b64_tr_b16 v[100:101], v160 offset:13840
    ds_read_b64_tr_b16 v[102:103], v160 offset:14032
    v_mfma_f32_16x16x32_bf16 v[200:203], v[88:91], v[40:43], 0
    ds_read_b128 v[40:43], v12 offset:15744
    ds_read_b64_tr_b16 v[72:73], v159 offset:27648
    ds_read_b64_tr_b16 v[74:75], v159 offset:27840
    v_mfma_f32_16x16x32_bf16 v[192:195], v[120:123], v[44:47], v[192:195]
    ds_read_b64_tr_b16 v[76:77], v156 offset:27664
    ds_read_b64_tr_b16 v[78:79], v156 offset:27856
    v_mfma_f32_16x16x32_bf16 v[196:199], v[124:127], v[44:47], v[196:199]
    ds_read_b64_tr_b16 v[112:113], v163 offset:27648
    ds_read_b64_tr_b16 v[114:115], v163 offset:27840
    v_mfma_f32_16x16x32_bf16 v[200:203], v[128:131], v[44:47], v[200:203]
    ds_read_b128 v[44:47], v13 offset:15744
    ds_read_b64_tr_b16 v[116:117], v160 offset:27664
    ds_read_b64_tr_b16 v[118:119], v160 offset:27856
    v_mfma_f32_16x16x32_bf16 v[192:195], v[144:147], v[48:51], v[192:195]
    ds_read_b64_tr_b16 v[132:133], v165 offset:27648
    ds_read_b64_tr_b16 v[134:135], v165 offset:27840
    v_mfma_f32_16x16x32_bf16 v[196:199], v[148:151], v[48:51], v[196:199]
    ds_read_b64_tr_b16 v[136:137], v167 offset:13824
    ds_read_b64_tr_b16 v[138:139], v167 offset:14016
    v_mfma_f32_16x16x32_bf16 v[200:203], v[152:155], v[48:51], v[200:203]
    ds_read_b128 v[48:51], v14 offset:6144
    ds_read_b64_tr_b16 v[140:141], v164 offset:13840
    ds_read_b64_tr_b16 v[142:143], v164 offset:14032
    ds_write_b32 v22, v23
    s_waitcnt lgkmcnt(15)
    v_mfma_f32_16x16x32_bf16 v[216:219], v[64:67], v[32:35], 0
    v_add_u32 v12, s36, v12
    v_mfma_f32_16x16x32_bf16 v[220:223], v[68:71], v[32:35], 0
    v_add_u32 v13, s36, v13
    s_waitcnt lgkmcnt(15)
    v_mfma_f32_16x16x32_bf16 v[216:219], v[104:107], v[36:39], v[216:219]
    v_add_u32 v14, s36, v14
    v_mfma_f32_16x16x32_bf16 v[220:223], v[108:111], v[36:39], v[220:223]
    s_waitcnt lgkmcnt(15)
    v_mfma_f32_16x16x32_bf16 v[216:219], v[80:83], v[40:43], v[216:219]
    v_mfma_f32_16x16x32_bf16 v[220:223], v[84:87], v[40:43], v[220:223]
    v_mfma_f32_16x16x32_bf16 v[224:227], v[88:91], v[40:43], 0
    s_waitcnt lgkmcnt(10)
    v_mfma_f32_16x16x32_bf16 v[216:219], v[120:123], v[44:47], v[216:219]
    v_mfma_f32_16x16x32_bf16 v[220:223], v[124:127], v[44:47], v[220:223]
    v_mfma_f32_16x16x32_bf16 v[224:227], v[128:131], v[44:47], v[224:227]
    s_waitcnt lgkmcnt(3)
    v_mfma_f32_16x16x32_bf16 v[216:219], v[144:147], v[48:51], v[216:219]
    v_mfma_f32_16x16x32_bf16 v[220:223], v[148:151], v[48:51], v[220:223]
    v_mfma_f32_16x16x32_bf16 v[224:227], v[152:155], v[48:51], v[224:227]
L_poll3:
    s_sub_u32 s46, s46, 1
    s_cbranch_scc1 L_end
    ds_read_b64 v[20:21], v18
    s_waitcnt lgkmcnt(0)
    v_min_u32 v20, v20, v21
    s_nop 0
    v_readfirstlane_b32 s35, v20
    s_cmp_ge_u32 s35, 2
    s_cbranch_scc0 L_poll3
    ds_read_b128 v[32:35], v12
    ds_read_b128 v[36:39], v13
    ds_read_b128 v[40:43], v12 offset:9600
    ds_read_b128 v[44:47], v13 offset:9600
    ds_read_b128 v[48:51], v14
    s_mov_b32 s34, 2
    v_subrev_u32 v15, s36, v15
    v_subrev_u32 v16, s36, v16
    v_subrev_u32 v17, s36, v17
    s_waitcnt lgkmcnt(0)
.p2align 3
L_loop:
    s_waitcnt lgkmcnt(8)
    v_mfma_f32_16x16x32_bf16 v[156:159], v[52:55], v[32:35], v[168:171]
    v_mfma_f32_16x16x32_bf16 v[160:163], v[56:59], v[32:35], v[172:175]
    v_mfma_f32_16x16x32_bf16 v[164:167], v[60:63], v[32:35], v[176:179]
    s_waitcnt lgkmcnt(7)
    v_mfma_f32_16x16x32_bf16 v[156:159], v[92:95], v[36:39], v[156:159]
    v_mfma_f32_16x16x32_bf16 v[160:163], v[96:99], v[36:39], v[160:163]
    v_add_u32 v15, s36, v15
    v_mfma_f32_16x16x32_bf16 v[164:167], v[100:103], v[36:39], v[164:167]
    s_waitcnt lgkmcnt(5)
    v_mfma_f32_16x16x32_bf16 v[160:163], v[72:75], v[40:43], v[160:163]
    v_add_u32 v16, s36, v16
    v_mfma_f32_16x16x32_bf16 v[164:167], v[76:79], v[40:43], v[164:167]
    s_waitcnt lgkmcnt(4)
    v_mfma_f32_16x16x32_bf16 v[160:163], v[112:115], v[44:47], v[160:163]
    v_add_u32 v17, s36, v17
    v_mfma_f32_16x16x32_bf16 v[164:167], v[116:119], v[44:47], v[164:167]
    s_waitcnt lgkmcnt(2)
    v_mfma_f32_16x16x32_bf16 v[156:159], v[132:135], v[48:51], v[156:159]
    v_mfma_f32_16x16x32_bf16 v[160:163], v[136:139], v[48:51], v[160:163]
    v_mfma_f32_16x16x32_bf16 v[164:167], v[140:143], v[48:51], v[164:167]
    v_mfma_f32_16x16x32_bf16 v[168:171], v[64:67], v[32:35], 0
    v_cvt_pk_bf16_f32 v26, v156, v157
    v_mfma_f32_16x16x32_bf16 v[172:175], v[68:71], v[32:35], 0
    ds_read_b128 v[32:35], v12 offset:3072
    v_mfma_f32_16x16x32_bf16 v[168:171], v[104:107], v[36:39], v[168:171]
    v_cvt_pk_bf16_f32 v27, v158, v159
    v_mfma_f32_16x16x32_bf16 v[172:175], v[108:111], v[36:39], v[172:175]
    ds_read_b128 v[36:39], v13 offset:3072
    v_mfma_f32_16x16x32_bf16 v[168:171], v[80:83], v[40:43], v[168:171]
    v_cvt_pk_bf16_f32 v28, v160, v161
    v_mfma_f32_16x16x32_bf16 v[172:175], v[84:87], v[40:43], v[172:175]
    ds_write_b64 v15, v[26:27]
    v_mfma_f32_16x16x32_bf16 v[176:179], v[88:91], v[40:43], 0
    ds_read_b128 v[40:43], v12 offset:12672
    v_mfma_f32_16x16x32_bf16 v[168:171], v[120:123], v[44:47], v[168:171]
    v_cvt_pk_bf16_f32 v29, v162, v163
    v_mfma_f32_16x16x32_bf16 v[172:175], v[124:127], v[44:47], v[172:175]
    v_cvt_pk_bf16_f32 v30, v164, v165
    v_mfma_f32_16x16x32_bf16 v[176:179], v[128:131], v[44:47], v[176:179]
    ds_read_b128 v[44:47], v13 offset:12672
    v_mfma_f32_16x16x32_bf16 v[168:171], v[144:147], v[48:51], v[168:171]
    ds_write_b64 v16, v[28:29]
    v_mfma_f32_16x16x32_bf16 v[172:175], v[148:151], v[48:51], v[172:175]
    v_cvt_pk_bf16_f32 v31, v166, v167
    v_mfma_f32_16x16x32_bf16 v[176:179], v[152:155], v[48:51], v[176:179]
    ds_read_b128 v[48:51], v14 offset:3072
    s_waitcnt lgkmcnt(6)
    v_mfma_f32_16x16x32_bf16 v[180:183], v[52:55], v[32:35], v[192:195]
    ds_write_b64 v17, v[30:31]
    v_mfma_f32_16x16x32_bf16 v[184:187], v[56:59], v[32:35], v[196:199]
    v_add_u32 v23, 1, v23
    v_mfma_f32_16x16x32_bf16 v[188:191], v[60:63], v[32:35], v[200:203]
    s_waitcnt lgkmcnt(6)
    v_mfma_f32_16x16x32_bf16 v[180:183], v[92:95], v[36:39], v[180:183]
    ds_write_b32 v22, v23
    v_mfma_f32_16x16x32_bf16 v[184:187], v[96:99], v[36:39], v[184:187]
    v_mfma_f32_16x16x32_bf16 v[188:191], v[100:103], v[36:39], v[188:191]
    s_waitcnt lgkmcnt(5)
    v_mfma_f32_16x16x32_bf16 v[184:187], v[72:75], v[40:43], v[184:187]
    v_mfma_f32_16x16x32_bf16 v[188:191], v[76:79], v[40:43], v[188:191]
    s_waitcnt lgkmcnt(4)
    v_mfma_f32_16x16x32_bf16 v[184:187], v[112:115], v[44:47], v[184:187]
    v_mfma_f32_16x16x32_bf16 v[188:191], v[116:119], v[44:47], v[188:191]
    s_waitcnt lgkmcnt(2)
    v_mfma_f32_16x16x32_bf16 v[180:183], v[132:135], v[48:51], v[180:183]
    v_mfma_f32_16x16x32_bf16 v[184:187], v[136:139], v[48:51], v[184:187]
    ds_read_b64 v[20:21], v18
    v_mfma_f32_16x16x32_bf16 v[188:191], v[140:143], v[48:51], v[188:191]
    v_mfma_f32_16x16x32_bf16 v[192:195], v[64:67], v[32:35], 0
    v_cvt_pk_bf16_f32 v26, v180, v181
    v_mfma_f32_16x16x32_bf16 v[196:199], v[68:71], v[32:35], 0
    ds_read_b128 v[32:35], v12 offset:6144
    v_mfma_f32_16x16x32_bf16 v[192:195], v[104:107], v[36:39], v[192:195]
    v_cvt_pk_bf16_f32 v27, v182, v183
    v_mfma_f32_16x16x32_bf16 v[196:199], v[108:111], v[36:39], v[196:199]
    ds_read_b128 v[36:39], v13 offset:6144
    v_mfma_f32_16x16x32_bf16 v[192:195], v[80:83], v[40:43], v[192:195]
    v_cvt_pk_bf16_f32 v28, v184, v185
    v_mfma_f32_16x16x32_bf16 v[196:199], v[84:87], v[40:43], v[196:199]
    ds_write_b64 v15, v[26:27] offset:3072
    v_mfma_f32_16x16x32_bf16 v[200:203], v[88:91], v[40:43], 0
    ds_read_b128 v[40:43], v12 offset:15744
    v_mfma_f32_16x16x32_bf16 v[192:195], v[120:123], v[44:47], v[192:195]
    v_cvt_pk_bf16_f32 v29, v186, v187
    v_mfma_f32_16x16x32_bf16 v[196:199], v[124:127], v[44:47], v[196:199]
    v_cvt_pk_bf16_f32 v30, v188, v189
    v_mfma_f32_16x16x32_bf16 v[200:203], v[128:131], v[44:47], v[200:203]
    ds_read_b128 v[44:47], v13 offset:15744
    v_mfma_f32_16x16x32_bf16 v[192:195], v[144:147], v[48:51], v[192:195]
    ds_write_b64 v16, v[28:29] offset:3072
    v_mfma_f32_16x16x32_bf16 v[196:199], v[148:151], v[48:51], v[196:199]
    v_cvt_pk_bf16_f32 v31, v190, v191
    v_mfma_f32_16x16x32_bf16 v[200:203], v[152:155], v[48:51], v[200:203]
    ds_read_b128 v[48:51], v14 offset:6144
    s_waitcnt lgkmcnt(6)
    v_mfma_f32_16x16x32_bf16 v[204:207], v[52:55], v[32:35], v[216:219]
    ds_write_b64 v17, v[30:31] offset:3072
    v_mfma_f32_16x16x32_bf16 v[208:211], v[56:59], v[32:35], v[220:223]
    v_add_u32 v23, 1, v23
    v_mfma_f32_16x16x32_bf16 v[212:215], v[60:63], v[32:35], v[224:227]
    s_waitcnt lgkmcnt(6)
    v_mfma_f32_16x16x32_bf16 v[204:207], v[92:95], v[36:39], v[204:207]
    ds_write_b32 v22, v23
    v_mfma_f32_16x16x32_bf16 v[208:211], v[96:99], v[36:39], v[208:211]
    v_add_u32 v12, s36, v12
    v_mfma_f32_16x16x32_bf16 v[212:215], v[100:103], v[36:39], v[212:215]
    s_waitcnt lgkmcnt(5)
    v_mfma_f32_16x16x32_bf16 v[208:211], v[72:75], v[40:43], v[208:211]
    v_add_u32 v13, s36, v13
    v_mfma_f32_16x16x32_bf16 v[212:215], v[76:79], v[40:43], v[212:215]
    s_waitcnt lgkmcnt(4)
    v_mfma_f32_16x16x32_bf16 v[208:211], v[112:115], v[44:47], v[208:211]
    v_add_u32 v14, s36, v14
    v_mfma_f32_16x16x32_bf16 v[212:215], v[116:119], v[44:47], v[212:215]
    s_waitcnt lgkmcnt(2)
    v_mfma_f32_16x16x32_bf16 v[204:207], v[132:135], v[48:51], v[204:207]
    v_min_u32 v20, v20, v21
    v_mfma_f32_16x16x32_bf16 v[208:211], v[136:139], v[48:51], v[208:211]
    s_add_u32 s34, s34, 1
    v_mfma_f32_16x16x32_bf16 v[212:215], v[140:143], v[48:51], v[212:215]
    v_readfirstlane_b32 s35, v20
    v_mfma_f32_16x16x32_bf16 v[216:219], v[64:67], v[32:35], 0
    s_cmp_gt_u32 s34, s35
    s_cbranch_scc1 L_slow
L_go:
    v_cvt_pk_bf16_f32 v26, v204, v205
    v_mfma_f32_16x16x32_bf16 v[220:223], v[68:71], v[32:35], 0
    ds_read_b128 v[32:35], v12
    v_mfma_f32_16x16x32_bf16 v[216:219], v[104:107], v[36:39], v[216:219]
    v_cvt_pk_bf16_f32 v27, v206, v207
    v_mfma_f32_16x16x32_bf16 v[220:223], v[108:111], v[36:39], v[220:223]
    ds_read_b128 v[36:39], v13
    v_mfma_f32_16x16x32_bf16 v[216:219], v[80:83], v[40:43], v[216:219]
    v_cvt_pk_bf16_f32 v28, v208, v209
    v_mfma_f32_16x16x32_bf16 v[220:223], v[84:87], v[40:43], v[220:223]
    ds_write_b64 v15, v[26:27] offset:6144
    v_mfma_f32_16x16x32_bf16 v[224:227], v[88:91], v[40:43], 0
    ds_read_b128 v[40:43], v12 offset:9600
    v_mfma_f32_16x16x32_bf16 v[216:219], v[120:123], v[44:47], v[216:219]
    v_cvt_pk_bf16_f32 v29, v210, v211
    v_mfma_f32_16x16x32_bf16 v[220:223], v[124:127], v[44:47], v[220:223]
    v_cvt_pk_bf16_f32 v30, v212, v213
    v_mfma_f32_16x16x32_bf16 v[224:227], v[128:131], v[44:47], v[224:227]
    v_add_u32 v23, 1, v23
    ds_read_b128 v[44:47], v13 offset:9600
    v_mfma_f32_16x16x32_bf16 v[216:219], v[144:147], v[48:51], v[216:219]
    ds_write_b64 v16, v[28:29] offset:6144
    v_mfma_f32_16x16x32_bf16 v[220:223], v[148:151], v[48:51], v[220:223]
    v_cvt_pk_bf16_f32 v31, v214, v215
    v_mfma_f32_16x16x32_bf16 v[224:227], v[152:155], v[48:51], v[224:227]
    ds_read_b128 v[48:51], v14
    ds_write_b64 v17, v[30:31] offset:6144
    ds_write_b32 v22, v23
    s_cmp_lt_u32 s34, 7
    s_cbranch_scc1 L_loop
    s_waitcnt lgkmcnt(8)
    v_mfma_f32_16x16x32_bf16 v[156:159], v[52:55], v[32:35], v[168:171]
    v_add_u32 v15, s36, v15
    v_mfma_f32_16x16x32_bf16 v[160:163], v[56:59], v[32:35], v[172:175]
    v_add_u32 v16, s36, v16
    v_mfma_f32_16x16x32_bf16 v[164:167], v[60:63], v[32:35], v[176:179]
    ds_read_b128 v[32:35], v12 offset:3072
    s_waitcnt lgkmcnt(8)
    v_mfma_f32_16x16x32_bf16 v[156:159], v[92:95], v[36:39], v[156:159]
    v_add_u32 v17, s36, v17
    v_mfma_f32_16x16x32_bf16 v[160:163], v[96:99], v[36:39], v[160:163]
    v_mfma_f32_16x16x32_bf16 v[164:167], v[100:103], v[36:39], v[164:167]
    ds_read_b128 v[36:39], v13 offset:3072
    s_waitcnt lgkmcnt(7)
    v_mfma_f32_16x16x32_bf16 v[160:163], v[72:75], v[40:43], v[160:163]
    v_mfma_f32_16x16x32_bf16 v[164:167], v[76:79], v[40:43], v[164:167]
    ds_read_b128 v[40:43], v12 offset:12672
    s_waitcnt lgkmcnt(7)
    v_mfma_f32_16x16x32_bf16 v[160:163], v[112:115], v[44:47], v[160:163]
    v_mfma_f32_16x16x32_bf16 v[164:167], v[116:119], v[44:47], v[164:167]
    ds_read_b128 v[44:47], v13 offset:12672
    s_waitcnt lgkmcnt(6)
    v_mfma_f32_16x16x32_bf16 v[156:159], v[132:135], v[48:51], v[156:159]
    v_mfma_f32_16x16x32_bf16 v[160:163], v[136:139], v[48:51], v[160:163]
    v_mfma_f32_16x16x32_bf16 v[164:167], v[140:143], v[48:51], v[164:167]
    ds_read_b128 v[48:51], v14 offset:3072
    s_waitcnt lgkmcnt(4)
    v_mfma_f32_16x16x32_bf16 v[180:183], v[52:55], v[32:35], v[192:195]
    v_cvt_pk_bf16_f32 v26, v156, v157
    v_mfma_f32_16x16x32_bf16 v[184:187], v[56:59], v[32:35], v[196:199]
    v_cvt_pk_bf16_f32 v27, v158, v159
    v_mfma_f32_16x16x32_bf16 v[188:191], v[60:63], v[32:35], v[200:203]
    ds_read_b128 v[32:35], v12 offset:6144
    v_cvt_pk_bf16_f32 v28, v160, v161
    s_waitcnt lgkmcnt(4)
    v_mfma_f32_16x16x32_bf16 v[180:183], v[92:95], v[36:39], v[180:183]
    v_cvt_pk_bf16_f32 v29, v162, v163
    v_mfma_f32_16x16x32_bf16 v[184:187], v[96:99], v[36:39], v[184:187]
    ds_write_b64 v15, v[26:27]
    v_mfma_f32_16x16x32_bf16 v[188:191], v[100:103], v[36:39], v[188:191]
    ds_read_b128 v[36:39], v13 offset:6144
    v_cvt_pk_bf16_f32 v30, v164, v165
    s_waitcnt lgkmcnt(5)
    v_mfma_f32_16x16x32_bf16 v[184:187], v[72:75], v[40:43], v[184:187]
    v_cvt_pk_bf16_f32 v31, v166, v167
    v_mfma_f32_16x16x32_bf16 v[188:191], v[76:79], v[40:43], v[188:191]
    ds_read_b128 v[40:43], v12 offset:15744
    ds_write_b64 v16, v[28:29]
    s_waitcnt lgkmcnt(6)
    v_mfma_f32_16x16x32_bf16 v[184:187], v[112:115], v[44:47], v[184:187]
    ds_write_b64 v17, v[30:31]
    v_mfma_f32_16x16x32_bf16 v[188:191], v[116:119], v[44:47], v[188:191]
    ds_read_b128 v[44:47], v13 offset:15744
    s_waitcnt lgkmcnt(7)
    v_mfma_f32_16x16x32_bf16 v[180:183], v[132:135], v[48:51], v[180:183]
    v_add_u32 v23, 1, v23
    v_mfma_f32_16x16x32_bf16 v[184:187], v[136:139], v[48:51], v[184:187]
    ds_write_b32 v22, v23
    v_mfma_f32_16x16x32_bf16 v[188:191], v[140:143], v[48:51], v[188:191]
    ds_read_b128 v[48:51], v14 offset:6144
    s_waitcnt lgkmcnt(8)
    v_mfma_f32_16x16x32_bf16 v[204:207], v[52:55], v[32:35], v[216:219]
    v_cvt_pk_bf16_f32 v26, v180, v181
    v_mfma_f32_16x16x32_bf16 v[208:211], v[56:59], v[32:35], v[220:223]
    v_cvt_pk_bf16_f32 v27, v182, v183
    v_mfma_f32_16x16x32_bf16 v[212:215], v[60:63], v[32:35], v[224:227]
    v_cvt_pk_bf16_f32 v28, v184, v185
    s_waitcnt lgkmcnt(6)
    v_mfma_f32_16x16x32_bf16 v[204:207], v[92:95], v[36:39], v[204:207]
    v_cvt_pk_bf16_f32 v29, v186, v187
    v_mfma_f32_16x16x32_bf16 v[208:211], v[96:99], v[36:39], v[208:211]
    ds_write_b64 v15, v[26:27] offset:3072
    v_mfma_f32_16x16x32_bf16 v[212:215], v[100:103], v[36:39], v[212:215]
    v_cvt_pk_bf16_f32 v30, v188, v189
    s_waitcnt lgkmcnt(6)
    v_mfma_f32_16x16x32_bf16 v[208:211], v[72:75], v[40:43], v[208:211]
    v_cvt_pk_bf16_f32 v31, v190, v191
    v_mfma_f32_16x16x32_bf16 v[212:215], v[76:79], v[40:43], v[212:215]
    ds_write_b64 v16, v[28:29] offset:3072
    s_waitcnt lgkmcnt(4)
    v_mfma_f32_16x16x32_bf16 v[208:211], v[112:115], v[44:47], v[208:211]
    ds_write_b64 v17, v[30:31] offset:3072
    v_mfma_f32_16x16x32_bf16 v[212:215], v[116:119], v[44:47], v[212:215]
    s_waitcnt lgkmcnt(3)
    v_mfma_f32_16x16x32_bf16 v[204:207], v[132:135], v[48:51], v[204:207]
    v_add_u32 v23, 1, v23
    v_mfma_f32_16x16x32_bf16 v[208:211], v[136:139], v[48:51], v[208:211]
    ds_write_b32 v22, v23
    v_mfma_f32_16x16x32_bf16 v[212:215], v[140:143], v[48:51], v[212:215]
    s_nop 5
    v_cvt_pk_bf16_f32 v26, v204, v205
    v_cvt_pk_bf16_f32 v27, v206, v207
    v_cvt_pk_bf16_f32 v28, v208, v209
    v_cvt_pk_bf16_f32 v29, v210, v211
    ds_write_b64 v15, v[26:27] offset:6144
    v_cvt_pk_bf16_f32 v30, v212, v213
    v_cvt_pk_bf16_f32 v31, v214, v215
    ds_write_b64 v16, v[28:29] offset:6144
    ds_write_b64 v17, v[30:31] offset:6144
    v_add_u32 v23, 1, v23
    ds_write_b32 v22, v23
    s_branch L_end
L_slow:
    s_sub_u32 s46, s46, 1
    s_cbranch_scc1 L_end
    ds_read_b64 v[20:21], v18
    s_waitcnt lgkmcnt(0)
    v_min_u32 v20, v20, v21
    s_nop 0
    v_readfirstlane_b32 s35, v20
    s_cmp_ge_u32 s35, s34
    s_cbranch_scc1 L_go
    s_branch L_slow
L_end:
    s_endpgm
L_comp:
    v_and_b32 v2, 15, v1
    v_lshrrev_b32 v3, 4, v1
    s_and_b32 s37, s24, 1
    s_mov_b32 s36, 19200
    v_and_b32 v28, 1, v3
    v_add_u32 v28, 1, v28
    v_lshrrev_b32 v29, 1, v3
    v_cmp_gt_u32 vcc, 2, v3
    s_add_u32 s29, s37, 1
    v_subrev_u32 v4, s29, v3
    v_cndmask_b32 v30, 0, v28, vcc
    v_cndmask_b32 v31, v4, 2, vcc
    s_mul_i32 s29, s24, 3
    v_add_u32 v4, v2, v28
    v_bfe_u32 v5, v4, 2, 2
    v_add_u32 v6, s29, v29
    v_xor_b32 v5, v5, v6
    v_mul_u32_u24 v4, 192, v4
    v_lshl_add_u32 v12, v5, 4, v4
    v_add_u32 v4, v2, v30
    v_bfe_u32 v5, v4, 2, 2
    v_add_u32 v6, s29, v31
    v_xor_b32 v5, v5, v6
    v_mul_u32_u24 v4, 192, v4
    v_lshl_add_u32 v13, v5, 4, v4
    s_lshl1_add_u32 s30, s37, s29
    v_bfe_u32 v5, v2, 2, 2
    v_xor_b32 v5, s30, v5
    v_mul_u32_u24 v4, 192, v2
    v_lshl_add_u32 v14, v5, 4, v4
    v_mul_u32_u24 v4, 9600, v29
    v_add_u32 v14, v14, v4
    s_mul_i32 s30, s24, 1152
    s_add_u32 s30, s30, 120768
    v_bfe_u32 v4, v1, 2, 2
    v_mul_u32_u24 v4, 48, v4
    v_and_b32 v5, 3, v1
    v_lshlrev_b32 v5, 3, v5
    v_add3_u32 v4, v4, v5, s30
    v_bfe_u32 v5, v1, 1, 1
    v_lshlrev_b32 v26, 18, v5
    v_xor_b32 v27, 262144, v26
    v_mul_u32_u24 v5, 13872, v5
    v_sub_u32 v25, 13856, v5
    v_mul_u32_u24 v5, 4608, v28
    v_mul_u32_u24 v6, 384, v29
    v_add3_u32 v156, v4, v5, v6
    v_add_u32 v157, v156, v25
    v_add3_u32 v158, v156, v26, 32
    v_add3_u32 v159, v156, v27, -16
    v_mul_u32_u24 v5, 4608, v30
    v_mul_u32_u24 v6, 384, v31
    v_add3_u32 v160, v4, v5, v6
    v_add_u32 v161, v160, v25
    v_add3_u32 v162, v160, v26, 32
    v_add3_u32 v163, v160, v27, -16
    s_mul_i32 s31, s37, 768
    v_mul_u32_u24 v5, 13824, v29
    v_add3_u32 v164, v4, v5, s31
    v_and_b32 v5, 1, v3
    v_lshl_add_u32 v164, v5, 18, v164
    v_lshlrev_b32 v5, 18, v29
    v_xor_b32 v6, 262144, v5
    v_add_u32 v165, v164, v5
    v_subrev_u32 v166, 13824, v164
    v_add_u32 v180, v166, v25
    v_add_u32 v166, v166, v6
    v_and_b32 v6, v6, v26
    v_add_u32 v180, v180, v6
    v_and_b32 v5, v5, v27
    v_add3_u32 v167, v164, v25, v5
    s_mul_i32 s29, s24, 6
    v_add_u32 v7, 1, v2
    v_bfe_u32 v6, v7, 2, 2
    v_mul_u32_u24 v7, 192, v7
    v_add_u32 v4, s29, v3
    v_lshrrev_b32 v5, 1, v4
    v_xor_b32 v5, v5, v6
    v_lshl_add_u32 v15, v5, 4, v7
    v_and_b32 v5, 1, v4
    v_lshl_add_u32 v15, v5, 3, v15
    v_add_u32 v4, 2, v4
    v_lshrrev_b32 v5, 1, v4
    v_xor_b32 v5, v5, v6
    v_lshl_add_u32 v17, v5, 4, v7
    v_and_b32 v5, 1, v4
    v_lshl_add_u32 v17, v5, 3, v17
    v_add_u32 v17, 9600, v17
    v_mul_u32_u24 v5, 6, v29
    v_sub_u32 v4, v4, v5
    v_add_u32 v4, 2, v4
    v_lshrrev_b32 v5, 1, v4
    v_xor_b32 v5, v5, v6
    v_lshl_add_u32 v16, v5, 4, v7
    v_and_b32 v5, 1, v4
    v_lshl_add_u32 v16, v5, 3, v16
    v_mul_u32_u24 v5, 9600, v29
    v_add_u32 v16, v16, v5
    v_mov_b32 v18, 163792
    v_mov_b32 v22, 163776
    v_lshl_add_u32 v22, s24, 2, v22
    v_mov_b32 v23, 1
    v_mov_b32 v24, 163800
    s_barrier
L_poll0:
    s_sub_u32 s46, s46, 1
    s_cbranch_scc1 L_end
    ds_read_b64 v[20:21], v24
    s_waitcnt lgkmcnt(0)
    v_min_u32 v20, v20, v21
    s_nop 0
    v_readfirstlane_b32 s35, v20
    s_cmp_ge_u32 s35, 1
    s_cbranch_scc0 L_poll0
    ds_read_b64_tr_b16 v[64:65], v156 offset:0
    ds_read_b64_tr_b16 v[66:67], v156 offset:192
    ds_read_b64_tr_b16 v[68:69], v158 offset:0
    ds_read_b64_tr_b16 v[70:71], v158 offset:192
    ds_read_b64_tr_b16 v[104:105], v160 offset:0
    ds_read_b64_tr_b16 v[106:107], v160 offset:192
    ds_read_b64_tr_b16 v[108:109], v162 offset:0
    ds_read_b64_tr_b16 v[110:111], v162 offset:192
    ds_read_b64_tr_b16 v[80:81], v156 offset:13824
    ds_read_b64_tr_b16 v[82:83], v156 offset:14016
    ds_read_b64_tr_b16 v[84:85], v157 offset:0
    ds_read_b64_tr_b16 v[86:87], v157 offset:192
    ds_read_b64_tr_b16 v[88:89], v156 offset:16
    ds_read_b64_tr_b16 v[90:91], v156 offset:208
    ds_read_b64_tr_b16 v[120:121], v160 offset:13824
    ds_read_b64_tr_b16 v[122:123], v160 offset:14016
    ds_read_b64_tr_b16 v[124:125], v161 offset:0
    ds_read_b64_tr_b16 v[126:127], v161 offset:192
    ds_read_b64_tr_b16 v[128:129], v160 offset:16
    ds_read_b64_tr_b16 v[130:131], v160 offset:208
    ds_read_b64_tr_b16 v[144:145], v164 offset:0
    ds_read_b64_tr_b16 v[146:147], v164 offset:192
    ds_read_b64_tr_b16 v[148:149], v180 offset:0
    ds_read_b64_tr_b16 v[150:151], v180 offset:192
    ds_read_b64_tr_b16 v[152:153], v166 offset:16
    ds_read_b64_tr_b16 v[154:155], v166 offset:208
L_poll1:
    s_sub_u32 s46, s46, 1
    s_cbranch_scc1 L_end
    ds_read_b64 v[20:21], v18
    s_waitcnt lgkmcnt(0)
    v_min_u32 v20, v20, v21
    s_nop 0
    v_readfirstlane_b32 s35, v20
    s_cmp_ge_u32 s35, 1
    s_cbranch_scc0 L_poll1
    s_branch L_comp2
L_codeend:
    s_endpgm
.section .rodata,"a"
.p2align 6
.amdhsa_kernel standalone__grouped__vision_kernel
  .amdhsa_next_free_vgpr 228
  .amdhsa_next_free_sgpr 102
  .amdhsa_accum_offset 228
  .amdhsa_group_segment_fixed_size 0
  .amdhsa_kernarg_size 40
  .amdhsa_user_sgpr_count 2
  .amdhsa_user_sgpr_kernarg_segment_ptr 1
  .amdhsa_system_sgpr_workgroup_id_x 1
.end_amdhsa_kernel
```
